```python
import torch

def _softmax(x, axis=-1):
    return torch.softmax(x, dim=axis)
def _gelu(x):
    return torch.nn.functional.gelu(x, approximate="tanh")
def _silu(x):
    return torch.nn.functional.silu(x)
def _sigmoid(x):
    return torch.sigmoid(x)
def _layernorm(x, axis=-1, eps=1e-5):
    m = x.mean(dim=axis, keepdim=True)
    v = x.var(dim=axis, keepdim=True, unbiased=False)
    return (x - m) / torch.sqrt(v + eps)
def _scatter_add(tgt, idx, src, axis=0):
    return tgt.clone().index_add_(axis, idx, src)
def _segment_sum(src, seg, n):
    out = torch.zeros((n,) + src.shape[1:], dtype=src.dtype)
    return out.index_add_(0, seg, src)
def _pad(x, pw):
    flat = tuple(v for pair in reversed(pw) for v in pair)
    return torch.nn.functional.pad(x, flat)

kernel_name = 'gated_mix__mha_block_cached__geglu_ffn__decode'

def setup_inputs():

    _w = (lambda a: (lambda t: t.to(torch.bfloat16) if t.is_floating_point() else t)(torch.as_tensor(a)))
    def _A_setup():
        B, Sq, D = 2, 1, 512
        H, Sk, Dh = 32, 4096, 128
        return {
            "x": _w((lambda *s: torch.randn(*s, dtype=torch.bfloat16) * 0.05)(B, Sq, D)),
            "k_cache": _w((lambda *s: torch.randn(*s, dtype=torch.bfloat16) * 3.2)(B, H, Sk, Dh)),
            "v_cache": _w((lambda *s: torch.randn(*s, dtype=torch.bfloat16) * 0.8)(B, H, Sk, Dh)),
            "wq": _w((lambda *s: torch.randn(*s, dtype=torch.bfloat16) * 3.2)(D, H * Dh) * (D ** -0.5)),
            "wo": _w((lambda *s: torch.randn(*s, dtype=torch.bfloat16) * 0.8)(H * Dh, D) * ((H * Dh) ** -0.5)),
        }
    _A_in = _A_setup()

    def _B_setup():
        B, S, D, F = 2, 1, 512, 1376
        return {
            "x": _w((lambda *s: torch.randn(*s, dtype=torch.bfloat16) * 0.05)(B, S, D)),
            "w_gate": _w((lambda *s: torch.randn(*s, dtype=torch.bfloat16) * 0.05)(D, F)),
            "w_up": _w((lambda *s: torch.randn(*s, dtype=torch.bfloat16) * 0.05)(D, F)),
            "w_down": _w((lambda *s: torch.randn(*s, dtype=torch.bfloat16) * 0.05)(F, D)),
        }
    _B_in = _B_setup()

    return {
        "A_x": _A_in["x"],
        "A_k_cache": _A_in["k_cache"],
        "A_v_cache": _A_in["v_cache"],
        "A_wq": _A_in["wq"],
        "A_wo": _A_in["wo"],
        "B_x": _B_in["x"],
        "B_w_gate": _B_in["w_gate"],
        "B_w_up": _B_in["w_up"],
        "B_w_down": _B_in["w_down"],
        "gate_w": _w((lambda *s: torch.randn(*s, dtype=torch.bfloat16) * 0.05)(512) * 16.0),
    }

def reference(A_x, A_k_cache, A_v_cache, A_wq, A_wo, B_x, B_w_gate, B_w_up, B_w_down, gate_w):
    def _A_ref(x, k_cache, v_cache, wq, wo):
        B, Sq, D = x.shape
        H, Dh = 32, 128
        q = (lambda x, *d: x.permute(*d))((x @ wq).reshape(B, Sq, H, Dh), 0, 2, 1, 3)
        scores = torch.einsum("bhqd,bhkd->bhqk", q, k_cache) * (Dh ** -0.5)
        p = _softmax(scores, axis=-1)
        o = torch.einsum("bhqk,bhkd->bhqd", p, v_cache)
        return (lambda x, *d: x.permute(*d))(o, 0, 2, 1, 3).reshape(B, Sq, H * Dh) @ wo

    def _B_ref(x, w_gate, w_up, w_down):
        return (_gelu(x @ w_gate) * (x @ w_up)) @ w_down

    x = A_x
    g = _sigmoid((x * gate_w).sum(-1, keepdims=True))
    a = _A_ref(x, A_k_cache, A_v_cache, A_wq, A_wo)
    b = _B_ref(x, B_w_gate, B_w_up, B_w_down)
    return g * a + (1 - g) * b
```

```asm
; @launch grid=(256,1,1) block=(512,1,1) lds=152576
.amdgcn_target "amdgcn-amd-amdhsa--gfx950"
.text
.globl gated_mix__mha_block_cached__geglu_ffn__decode_kernel
.p2align 8
.type gated_mix__mha_block_cached__geglu_ffn__decode_kernel,@function
gated_mix__mha_block_cached__geglu_ffn__decode_kernel:
    s_cmp_ge_u32 s2, 256
    s_cbranch_scc1 L_end
    s_load_dwordx16 s[16:31], s[0:1], 0
    s_load_dwordx8 s[32:39], s[0:1], 64
    s_load_dwordx2 s[40:41], s[0:1], 96
    v_lshrrev_b32 v10, 6, v0
    v_and_b32 v2, 15, v0
    v_readfirstlane_b32 s3, v10
    v_bfe_u32 v3, v0, 4, 2
    s_and_b32 s8, s2, 7
    s_lshr_b32 s9, s2, 3
    s_and_b32 s10, s9, 3
    s_lshl_b32 s4, s8, 2
    s_add_u32 s4, s4, s10
    s_lshr_b32 s72, s9, 2
    s_and_b32 s73, s2, 31
    s_lshl_b32 s89, s8, 2
    s_lshr_b32 s89, 0x54ff3210, s89
    s_and_b32 s89, s89, 15
    s_mul_i32 s75, s10, 6
    s_add_u32 s75, s75, s89
    s_cmp_eq_u32 s89, 15
    s_cselect_b32 s75, 31, s75
    s_lshl_b32 s11, s72, 3
    s_add_u32 s11, s11, s3
    s_lshl_b32 s12, s11, 4
    s_lshl_b32 s42, s11, 16
    s_lshl_b32 s13, s4, 8
    s_add_u32 s42, s42, s13
    s_cmp_ge_u32 s75, 11
    s_cselect_b32 s43, 11, 0
    s_sub_u32 s43, s75, s43
    s_lshl_b32 s43, s43, 8
    s_mul_i32 s11, s11, 22016
    s_add_u32 s43, s43, s11
    s_sub_u32 s70, 1409024, s43
    s_cmp_lt_u32 s75, 22
    s_cselect_b32 s70, s70, 0
    s_cselect_b32 s43, s43, 0
    s_mov_b32 s71, 0x20000
    s_mov_b32 s62, 2048
    s_mov_b32 s63, 0x20000
    s_mov_b32 s54, 57600
    s_mov_b32 s55, 0x20000
    s_movk_i32 s13, 8192
    v_lshrrev_b32 v10, 3, v2
    v_lshlrev_b32 v10, 10, v10
    v_lshl_add_u32 v10, v3, 2, v10
    v_lshlrev_b32 v11, 4, v2
    v_lshl_add_u32 v6, v3, 14, v11
    v_mul_u32_u24 v8, 5504, v3
    v_add_u32 v8, v8, v11
    s_cmp_ge_u32 s75, 11
    s_waitcnt lgkmcnt(0)
    s_cselect_b32 s68, s30, s28
    s_cselect_b32 s69, s31, s29
    s_add_u32 s52, s22, s42
    s_addc_u32 s53, s23, 0
    buffer_load_dwordx4 v[88:91], v6, s[52:55], 0 offen nt
    buffer_load_dwordx4 v[92:95], v6, s[52:55], s13 offen nt
    s_add_u32 s68, s68, s43
    s_addc_u32 s69, s69, 0
    buffer_load_dwordx4 v[96:99], v8, s[68:71], 0 offen nt
    buffer_load_dwordx4 v[100:103], v8, s[68:71], 0 offen offset:2752 nt
    s_mov_b32 s60, s16
    s_mov_b32 s61, s17
    buffer_load_dword v16, v10, s[60:63], s12 offen
    s_mov_b32 s80, s40
    s_mov_b32 s81, s41
    s_mov_b32 s82, 544768
    s_mov_b32 s83, 0x20000
    s_cmp_lg_u32 s3, 0
    s_cbranch_scc1 L_skip_1
    v_mov_b32 v40, -1
    v_mov_b32 v41, -1
    v_mov_b32 v42, -1
    v_mov_b32 v43, -1
    v_and_b32 v44, 63, v0
    v_lshlrev_b32 v44, 4, v44
    s_lshl_b32 s15, s4, 3
    s_add_u32 s15, s15, s72
    s_lshl_b32 s15, s15, 10
    s_add_u32 s15, s15, 102400
    buffer_store_dwordx4 v[40:43], v44, s[80:83], s15 offen sc1
    s_lshl_b32 s15, s75, 3
    s_add_u32 s15, s15, s72
    s_lshl_b32 s15, s15, 10
    s_add_u32 s15, s15, 364544
    buffer_store_dwordx4 v[40:43], v44, s[80:83], s15 offen sc1
    s_mov_b32 exec_lo, 0xff
    s_mov_b32 exec_hi, 0x0
    s_lshl_b32 s15, s2, 7
    s_add_u32 s15, s15, 69632
    buffer_store_dwordx4 v[40:43], v44, s[80:83], s15 offen sc1
    v_mov_b32 v48, 0
    v_mov_b32 v49, 0
    v_mov_b32 v50, 0
    v_mov_b32 v51, 0
    s_mul_i32 s15, s2, 256
    s_cmp_lt_u32 s2, 128
    s_cselect_b32 s15, s15, 4194304
    buffer_store_dwordx4 v[48:51], v44, s[80:83], s15 offen sc1
    s_mov_b64 exec, -1
L_skip_1:
    v_and_b32 v1, 63, v0
    s_lshr_b32 s5, s72, 2
    s_and_b32 s6, s72, 3
    s_lshl_b32 s91, s5, 5
    s_add_u32 s91, s91, s4
    v_and_b32 v4, 7, v0
    v_lshlrev_b32 v4, 8, v4
    v_lshl_add_u32 v4, v3, 4, v4
    v_and_b32 v5, 8, v0
    v_lshl_add_u32 v4, v5, 3, v4
    v_lshl_add_u32 v5, v3, 10, v11
    s_lshl_b32 s11, s91, 20
    s_lshl_b32 s12, s6, 18
    s_add_u32 s11, s11, s12
    s_lshl_b32 s12, s3, 12
    s_add_u32 s11, s11, s12
    s_add_u32 s44, s18, s11
    s_addc_u32 s45, s19, 0
    s_mov_b32 s46, 233472
    s_mov_b32 s47, 0x20000
    s_add_u32 s48, s20, s11
    s_addc_u32 s49, s21, 0
    s_mov_b32 s50, 233472
    s_mov_b32 s51, 0x20000
    s_lshl_b32 s74, s72, 15
    s_mov_b32 s64, s34
    s_mov_b32 s65, s35
    s_mov_b32 s66, 1024
    s_mov_b32 s67, 0x20000
    s_lshl_b32 s89, s8, 2
    s_lshr_b32 s89, 0xf5f43210, s89
    s_and_b32 s89, s89, 15
    s_and_b32 s9, s9, 15
    s_mul_i32 s7, s89, 15
    s_add_u32 s7, s7, s9
    s_cmp_lt_u32 s9, 15
    s_cselect_b32 s7, s7, 1000
    s_cmp_lt_u32 s7, 86
    s_cselect_b32 s78, 15488, 0
    s_cselect_b32 s7, s7, 0
    s_lshl_b32 s8, s7, 14
    s_lshl_b32 s9, s3, 7
    s_add_u32 s8, s8, s9
    s_add_u32 s76, s32, s8
    s_addc_u32 s77, s33, 0
    s_mov_b32 s79, 0x20000
    s_lshl_b32 s8, s4, 17
    s_add_u32 s8, s8, s9
    s_add_u32 s56, s24, s8
    s_addc_u32 s57, s25, 0
    s_mov_b32 s58, 130176
    s_mov_b32 s59, 0x20000
    v_lshlrev_b32 v11, 4, v1
    v_and_b32 v108, 7, v1
    v_lshlrev_b32 v108, 4, v108
    v_lshrrev_b32 v109, 3, v1
    v_lshl_add_u32 v9, v109, 10, v108
    v_and_b32 v110, 3, v109
    v_lshlrev_b32 v110, 3, v110
    v_lshrrev_b32 v109, 2, v109
    v_add_u32 v109, v109, v110
    v_lshl_add_u32 v7, v109, 10, v108
    s_lshl_b32 s84, s3, 14
    s_add_u32 s84, s84, 21504
    s_lshl_b32 s85, s3, 11
    s_add_u32 s85, s85, 5120
    v_and_b32 v108, 1, v2
    v_lshlrev_b32 v108, 4, v108
    v_mov_b32 v109, 0xffff
    v_lshlrev_b32 v109, v108, v109
    v_bfe_u32 v108, v2, 1, 2
    v_cmp_eq_u32 vcc, 0, v108
    s_nop 1
    v_cndmask_b32 v12, 0, v109, vcc
    v_cmp_eq_u32 vcc, 1, v108
    s_nop 1
    v_cndmask_b32 v13, 0, v109, vcc
    v_cmp_eq_u32 vcc, 2, v108
    s_nop 1
    v_cndmask_b32 v14, 0, v109, vcc
    v_cmp_eq_u32 vcc, 3, v108
    s_nop 1
    v_cndmask_b32 v15, 0, v109, vcc
    s_mov_b32 s86, 0x01000100
    s_mov_b32 s87, 0x03020302
    s_mov_b32 s88, 0x3e0293ee
    s_add_u32 s8, s84, 14336
    v_lshl_add_u32 v10, v1, 4, s8
    s_cmp_lg_u32 s3, 0
    s_cbranch_scc1 L_skip_2
    s_waitcnt vmcnt(0)
L_skip_2:
    s_waitcnt vmcnt(3)
    s_xor_b32 s11, s74, 0
    buffer_load_dwordx4 v[112:115], v4, s[44:47], s11 offen offset:0 nt
    s_waitcnt vmcnt(2)
    buffer_load_dwordx4 v[116:119], v4, s[44:47], s11 offen offset:128 nt
    s_waitcnt vmcnt(2)
    buffer_load_dwordx4 v[120:123], v4, s[44:47], s11 offen offset:2048 nt
    s_waitcnt vmcnt(3)
    buffer_load_dwordx4 v[124:127], v4, s[44:47], s11 offen offset:2176 nt
    s_xor_b32 s11, s74, 32768
    buffer_load_dwordx4 v[128:131], v4, s[44:47], s11 offen offset:0 nt
    buffer_load_dwordx4 v[132:135], v4, s[44:47], s11 offen offset:128 nt
    buffer_load_dwordx4 v[136:139], v4, s[44:47], s11 offen offset:2048 nt
    buffer_load_dwordx4 v[140:143], v4, s[44:47], s11 offen offset:2176 nt
    v_perm_b32 v108, v16, v16, s86
    v_and_b32 v24, v108, v12
    v_and_b32 v25, v108, v13
    v_and_b32 v26, v108, v14
    v_and_b32 v27, v108, v15
    v_perm_b32 v109, v16, v16, s87
    v_and_b32 v28, v109, v12
    v_and_b32 v29, v109, v13
    v_and_b32 v30, v109, v14
    v_and_b32 v31, v109, v15
    s_nop 0
    v_mfma_f32_16x16x32_bf16 v[32:35], v[88:91], v[24:27], 0
    v_mfma_f32_16x16x32_bf16 v[36:39], v[96:99], v[24:27], 0
    v_mfma_f32_16x16x32_bf16 v[32:35], v[92:95], v[28:31], v[32:35]
    v_mfma_f32_16x16x32_bf16 v[36:39], v[100:103], v[28:31], v[36:39]
    s_nop 7
    ds_write_b128 v10, v[32:35]
    ds_write_b128 v10, v[36:39] offset:1024
    s_waitcnt lgkmcnt(0)
    s_cmp_lg_u32 s3, 0
    s_cbranch_scc1 L_skip_3
    s_lshl_b32 s14, s73, 3
    s_mov_b32 s42, 1
    s_atomic_add s42, s[38:39], s14 glc
L_skip_3:
    s_barrier
    s_cmp_lg_u32 s3, 1
    s_cbranch_scc1 L_skip_4
    v_add_u32 v10, 35840, v11
    v_add_u32 v104, 0x10000, v10
    ds_read_b128 v[56:59], v10 offset:0
    ds_read_b128 v[60:63], v10 offset:16384
    ds_read_b128 v[64:67], v10 offset:32768
    ds_read_b128 v[68:71], v10 offset:49152
    ds_read_b128 v[72:75], v104 offset:0
    ds_read_b128 v[76:79], v104 offset:16384
    ds_read_b128 v[80:83], v104 offset:32768
    ds_read_b128 v[84:87], v104 offset:49152
    ds_read_b128 v[208:211], v10 offset:1024
    ds_read_b128 v[212:215], v10 offset:17408
    ds_read_b128 v[216:219], v10 offset:33792
    ds_read_b128 v[220:223], v10 offset:50176
    s_lshl_b32 s8, s4, 3
    s_add_u32 s8, s8, s72
    s_lshl_b32 s8, s8, 10
    s_add_u32 s8, s8, 102400
    s_lshl_b32 s9, s75, 3
    s_add_u32 s9, s9, s72
    s_lshl_b32 s9, s9, 10
    s_add_u32 s9, s9, 364544
    s_waitcnt lgkmcnt(4)
    ds_read_b128 v[224:227], v104 offset:1024
    ds_read_b128 v[228:231], v104 offset:17408
    ds_read_b128 v[232:235], v104 offset:33792
    ds_read_b128 v[236:239], v104 offset:50176
    v_add_f32 v56, v56, v60
    v_add_f32 v57, v57, v61
    v_add_f32 v58, v58, v62
    v_add_f32 v59, v59, v63
    v_add_f32 v56, v56, v64
    v_add_f32 v57, v57, v65
    v_add_f32 v58, v58, v66
    v_add_f32 v59, v59, v67
    v_add_f32 v56, v56, v68
    v_add_f32 v57, v57, v69
    v_add_f32 v58, v58, v70
    v_add_f32 v59, v59, v71
    v_add_f32 v56, v56, v72
    v_add_f32 v57, v57, v73
    v_add_f32 v58, v58, v74
    v_add_f32 v59, v59, v75
    v_add_f32 v56, v56, v76
    v_add_f32 v57, v57, v77
    v_add_f32 v58, v58, v78
    v_add_f32 v59, v59, v79
    v_add_f32 v56, v56, v80
    v_add_f32 v57, v57, v81
    v_add_f32 v58, v58, v82
    v_add_f32 v59, v59, v83
    v_add_f32 v56, v56, v84
    v_add_f32 v57, v57, v85
    v_add_f32 v58, v58, v86
    v_add_f32 v59, v59, v87
    v_min_u32 v56, -2, v56
    v_min_u32 v57, -2, v57
    v_min_u32 v58, -2, v58
    v_min_u32 v59, -2, v59
    buffer_store_dwordx4 v[56:59], v11, s[80:83], s8 offen sc1
    s_waitcnt lgkmcnt(0)
    v_add_f32 v208, v208, v212
    v_add_f32 v209, v209, v213
    v_add_f32 v210, v210, v214
    v_add_f32 v211, v211, v215
    v_add_f32 v208, v208, v216
    v_add_f32 v209, v209, v217
    v_add_f32 v210, v210, v218
    v_add_f32 v211, v211, v219
    v_add_f32 v208, v208, v220
    v_add_f32 v209, v209, v221
    v_add_f32 v210, v210, v222
    v_add_f32 v211, v211, v223
    v_add_f32 v208, v208, v224
    v_add_f32 v209, v209, v225
    v_add_f32 v210, v210, v226
    v_add_f32 v211, v211, v227
    v_add_f32 v208, v208, v228
    v_add_f32 v209, v209, v229
    v_add_f32 v210, v210, v230
    v_add_f32 v211, v211, v231
    v_add_f32 v208, v208, v232
    v_add_f32 v209, v209, v233
    v_add_f32 v210, v210, v234
    v_add_f32 v211, v211, v235
    v_add_f32 v208, v208, v236
    v_add_f32 v209, v209, v237
    v_add_f32 v210, v210, v238
    v_add_f32 v211, v211, v239
    v_min_u32 v208, -2, v208
    v_min_u32 v209, -2, v209
    v_min_u32 v210, -2, v210
    v_min_u32 v211, -2, v211
    buffer_store_dwordx4 v[208:211], v11, s[80:83], s9 offen sc1
    s_nop 1
L_skip_4:
    s_xor_b32 s11, s74, 65536
    buffer_load_dwordx4 v[144:147], v4, s[44:47], s11 offen offset:0 nt
    s_cmp_lg_u32 s3, 2
    s_cbranch_scc1 L_skip_5
    s_lshl_b32 s9, s5, 10
    buffer_load_dwordx4 v[16:19], v11, s[60:63], s9 offen
    buffer_load_dwordx4 v[20:23], v11, s[64:67], 0 offen
L_skip_5:
    buffer_load_dwordx4 v[148:151], v4, s[44:47], s11 offen offset:128 nt
    s_waitcnt vmcnt(9)
    buffer_load_dwordx4 v[152:155], v4, s[44:47], s11 offen offset:2048 nt
    s_waitcnt vmcnt(9)
    s_cmp_lg_u32 s3, 0
    s_cbranch_scc1 L_skip_6
    s_lshl_b32 s43, s2, 7
    s_add_u32 s43, s43, 69632
    s_mov_b32 s87, 0
    v_lshlrev_b32 v44, 12, v1
    v_mov_b32 v46, 1
    s_lshl_b32 s8, s73, 7
    s_add_u32 s8, s8, 69632
    s_waitcnt lgkmcnt(0)
    s_and_b32 s42, s42, 7
    s_cmp_lg_u32 s42, 7
    s_cbranch_scc1 L_hswait_8
    s_mov_b32 exec_lo, 0xff
    s_mov_b32 exec_hi, 0x0
    buffer_store_dword v46, v44, s[80:83], s8 offen sc1
    s_mov_b64 exec, -1
    s_mov_b32 s86, 1
    s_branch L_hsend_7
L_hswait_8:
    s_load_dword s86, s[40:41], s43 glc
L_hsend_7:
L_skip_6:
    buffer_load_dwordx4 v[156:159], v4, s[44:47], s11 offen offset:2176 nt
    s_waitcnt vmcnt(9)
    s_add_u32 m0, s84, 0
    s_mov_b32 s15, 0
    buffer_load_dwordx4 v7, s[56:59], s15 offen nt lds
    s_waitcnt vmcnt(9)
    s_xor_b32 s11, s74, 98304
    buffer_load_dwordx4 v[160:163], v4, s[44:47], s11 offen offset:0 nt
    s_waitcnt vmcnt(9)
    buffer_load_dwordx4 v[164:167], v4, s[44:47], s11 offen offset:128 nt
    s_waitcnt vmcnt(9)
    buffer_load_dwordx4 v[168:171], v4, s[44:47], s11 offen offset:2048 nt
    s_waitcnt vmcnt(9)
    buffer_load_dwordx4 v[172:175], v4, s[44:47], s11 offen offset:2176 nt
    s_waitcnt vmcnt(9)
    s_add_u32 m0, s84, 1024
    s_mov_b32 s15, 2048
    buffer_load_dwordx4 v7, s[56:59], s15 offen nt lds
    s_waitcnt vmcnt(9)
    s_xor_b32 s11, s74, 131072
    buffer_load_dwordx4 v[176:179], v4, s[44:47], s11 offen offset:0 nt
    s_waitcnt vmcnt(9)
    s_cmp_lg_u32 s3, 2
    s_cbranch_scc1 L_skip_9
    v_mov_b32 v10, 0
    v_lshlrev_b32 v104, 16, v16
    v_lshlrev_b32 v105, 16, v20
    v_and_b32 v106, 0xffff0000, v16
    v_and_b32 v107, 0xffff0000, v20
    v_mul_f32 v104, v104, v105
    v_mul_f32 v106, v106, v107
    v_cvt_pk_bf16_f32 v104, v104, v106
    v_lshlrev_b32 v105, 16, v104
    v_and_b32 v104, 0xffff0000, v104
    v_add_f32 v10, v10, v105
    v_add_f32 v10, v10, v104
    v_lshlrev_b32 v104, 16, v17
    v_lshlrev_b32 v105, 16, v21
    v_and_b32 v106, 0xffff0000, v17
    v_and_b32 v107, 0xffff0000, v21
    v_mul_f32 v104, v104, v105
    v_mul_f32 v106, v106, v107
    v_cvt_pk_bf16_f32 v104, v104, v106
    v_lshlrev_b32 v105, 16, v104
    v_and_b32 v104, 0xffff0000, v104
    v_add_f32 v10, v10, v105
    v_add_f32 v10, v10, v104
    v_lshlrev_b32 v104, 16, v18
    v_lshlrev_b32 v105, 16, v22
    v_and_b32 v106, 0xffff0000, v18
    v_and_b32 v107, 0xffff0000, v22
    v_mul_f32 v104, v104, v105
    v_mul_f32 v106, v106, v107
    v_cvt_pk_bf16_f32 v104, v104, v106
    v_lshlrev_b32 v105, 16, v104
    v_and_b32 v104, 0xffff0000, v104
    v_add_f32 v10, v10, v105
    v_add_f32 v10, v10, v104
    v_lshlrev_b32 v104, 16, v19
    v_lshlrev_b32 v105, 16, v23
    v_and_b32 v106, 0xffff0000, v19
    v_and_b32 v107, 0xffff0000, v23
    v_mul_f32 v104, v104, v105
    v_mul_f32 v106, v106, v107
    v_cvt_pk_bf16_f32 v104, v104, v106
    v_lshlrev_b32 v105, 16, v104
    v_and_b32 v104, 0xffff0000, v104
    v_add_f32 v10, v10, v105
    v_add_f32 v10, v10, v104
    s_nop 1
    v_add_f32_dpp v10, v10, v10 quad_perm:[1,0,3,2] row_mask:0xf bank_mask:0xf
    s_nop 1
    v_add_f32_dpp v10, v10, v10 quad_perm:[2,3,0,1] row_mask:0xf bank_mask:0xf
    s_nop 1
    v_add_f32_dpp v10, v10, v10 row_half_mirror row_mask:0xf bank_mask:0xf
    s_nop 1
    v_add_f32_dpp v10, v10, v10 row_mirror row_mask:0xf bank_mask:0xf
    v_mov_b32 v104, v10
    s_nop 1
    v_permlane16_swap_b32 v10, v104
    s_nop 0
    v_add_f32 v10, v10, v104
    v_mov_b32 v104, v10
    s_nop 1
    v_permlane32_swap_b32 v10, v104
    s_nop 0
    v_add_f32 v10, v10, v104
    v_cvt_pk_bf16_f32 v10, v10, v10
    v_and_b32 v10, 0xffff0000, v10
    v_mul_f32 v10, 0xbfb8aa3b, v10
    v_exp_f32 v10, v10
    s_nop 0
    v_add_f32 v10, 1.0, v10
    v_rcp_f32 v10, v10
    s_nop 0
    v_cvt_pk_bf16_f32 v10, v10, v10
    v_and_b32 v104, 0xffff0000, v10
    v_sub_f32 v105, 1.0, v104
    v_cvt_pk_bf16_f32 v105, v105, v105
    v_and_b32 v105, 0xffff0000, v105
    v_mov_b32 v106, 0
    ds_write_b64 v106, v[104:105] offset:320
L_skip_9:
    buffer_load_dwordx4 v[180:183], v4, s[44:47], s11 offen offset:128 nt
    s_waitcnt vmcnt(9)
    buffer_load_dwordx4 v[184:187], v4, s[44:47], s11 offen offset:2048 nt
    s_waitcnt vmcnt(9)
    s_cmp_lg_u32 s3, 0
    s_cbranch_scc1 L_skip_10
    s_cmp_eq_u32 s87, 1
    s_cbranch_scc1 L_hsend_11
    s_waitcnt lgkmcnt(0)
    s_cmp_lg_u32 s86, 1
    s_cbranch_scc1 L_hswait_12
    s_lshl_b32 s8, s4, 13
    s_lshl_b32 s9, s5, 7
    s_add_u32 s8, s8, s9
    s_add_u32 s8, s8, 102400
    v_and_b32 v104, 7, v1
    v_lshlrev_b32 v104, 4, v104
    v_bfe_u32 v105, v1, 3, 2
    v_lshl_add_u32 v104, v105, 8, v104
    v_lshrrev_b32 v105, 5, v1
    v_lshl_add_u32 v104, v105, 10, v104
    s_add_u32 s9, s8, 4096
    buffer_load_dwordx4 v[56:59], v104, s[80:83], s8 offen offset:0 sc1
    buffer_load_dwordx4 v[60:63], v104, s[80:83], s8 offen offset:2048 sc1
    buffer_load_dwordx4 v[64:67], v104, s[80:83], s9 offen offset:0 sc1
    buffer_load_dwordx4 v[68:71], v104, s[80:83], s9 offen offset:2048 sc1
    s_mov_b32 s87, 1
    s_branch L_hsend_11
L_hswait_12:
    s_load_dword s86, s[40:41], s43 glc
L_hsend_11:
L_skip_10:
    buffer_load_dwordx4 v[188:191], v4, s[44:47], s11 offen offset:2176 nt
    s_waitcnt vmcnt(9)
    s_add_u32 m0, s84, 2048
    s_mov_b32 s15, 4096
    buffer_load_dwordx4 v7, s[56:59], s15 offen nt lds
    s_waitcnt vmcnt(9)
    s_add_u32 m0, s84, 3072
    s_mov_b32 s15, 6144
    buffer_load_dwordx4 v7, s[56:59], s15 offen nt lds
    s_waitcnt vmcnt(9)
    s_cmp_lg_u32 s3, 0
    s_cbranch_scc1 L_skip_13
    s_cmp_eq_u32 s87, 1
    s_cbranch_scc1 L_hsend_14
    s_waitcnt lgkmcnt(0)
    s_cmp_lg_u32 s86, 1
    s_cbranch_scc1 L_hswait_15
    s_lshl_b32 s8, s4, 13
    s_lshl_b32 s9, s5, 7
    s_add_u32 s8, s8, s9
    s_add_u32 s8, s8, 102400
    v_and_b32 v104, 7, v1
    v_lshlrev_b32 v104, 4, v104
    v_bfe_u32 v105, v1, 3, 2
    v_lshl_add_u32 v104, v105, 8, v104
    v_lshrrev_b32 v105, 5, v1
    v_lshl_add_u32 v104, v105, 10, v104
    s_add_u32 s9, s8, 4096
    buffer_load_dwordx4 v[56:59], v104, s[80:83], s8 offen offset:0 sc1
    buffer_load_dwordx4 v[60:63], v104, s[80:83], s8 offen offset:2048 sc1
    buffer_load_dwordx4 v[64:67], v104, s[80:83], s9 offen offset:0 sc1
    buffer_load_dwordx4 v[68:71], v104, s[80:83], s9 offen offset:2048 sc1
    s_mov_b32 s87, 1
    s_branch L_hsend_14
L_hswait_15:
    s_load_dword s86, s[40:41], s43 glc
L_hsend_14:
L_skip_13:
    s_xor_b32 s11, s74, 163840
    buffer_load_dwordx4 v[192:195], v4, s[44:47], s11 offen offset:0 nt
    s_waitcnt vmcnt(9)
    buffer_load_dwordx4 v[196:199], v4, s[44:47], s11 offen offset:128 nt
    s_waitcnt vmcnt(9)
    s_cmp_lg_u32 s3, 0
    s_cbranch_scc1 L_skip_16
    s_cmp_eq_u32 s87, 1
    s_cbranch_scc1 L_hsend_17
    s_waitcnt lgkmcnt(0)
    s_cmp_eq_u32 s86, 1
    s_cbranch_scc1 L_go_20
    s_mov_b32 s89, 0
    v_mov_b32 v104, 0
L_mbspin_19:
    s_mov_b64 exec, 1
    buffer_load_dword v111, v104, s[80:83], s43 offen sc1
    s_mov_b64 exec, -1
    s_add_u32 s89, s89, 1
    s_waitcnt vmcnt(0)
    v_readfirstlane_b32 s14, v111
    s_cmp_ge_u32 s89, 0x4000
    s_cbranch_scc1 L_go_20
    s_cmp_lg_u32 s14, 1
    s_cbranch_scc1 L_mbspin_19
L_go_20:
    s_lshl_b32 s8, s4, 13
    s_lshl_b32 s9, s5, 7
    s_add_u32 s8, s8, s9
    s_add_u32 s8, s8, 102400
    v_and_b32 v104, 7, v1
    v_lshlrev_b32 v104, 4, v104
    v_bfe_u32 v105, v1, 3, 2
    v_lshl_add_u32 v104, v105, 8, v104
    v_lshrrev_b32 v105, 5, v1
    v_lshl_add_u32 v104, v105, 10, v104
    s_add_u32 s9, s8, 4096
    buffer_load_dwordx4 v[56:59], v104, s[80:83], s8 offen offset:0 sc1
    buffer_load_dwordx4 v[60:63], v104, s[80:83], s8 offen offset:2048 sc1
    buffer_load_dwordx4 v[64:67], v104, s[80:83], s9 offen offset:0 sc1
    buffer_load_dwordx4 v[68:71], v104, s[80:83], s9 offen offset:2048 sc1
    s_mov_b32 s87, 1
L_hsend_17:
L_skip_16:
    buffer_load_dwordx4 v[200:203], v4, s[44:47], s11 offen offset:2048 nt
    s_waitcnt vmcnt(9)
    buffer_load_dwordx4 v[204:207], v4, s[44:47], s11 offen offset:2176 nt
    s_waitcnt vmcnt(9)
    s_add_u32 m0, s85, 0
    s_movk_i32 s15, 0
    buffer_load_dwordx4 v9, s[76:79], s15 offen nt lds
    s_waitcnt vmcnt(9)
    s_xor_b32 s11, s74, 196608
    buffer_load_dwordx4 v[208:211], v4, s[44:47], s11 offen offset:0 nt
    s_waitcnt vmcnt(9)
    buffer_load_dwordx4 v[212:215], v4, s[44:47], s11 offen offset:128 nt
    s_waitcnt vmcnt(9)
    buffer_load_dwordx4 v[216:219], v4, s[44:47], s11 offen offset:2048 nt
    s_waitcnt vmcnt(9)
    buffer_load_dwordx4 v[220:223], v4, s[44:47], s11 offen offset:2176 nt
    s_waitcnt vmcnt(9)
    s_add_u32 m0, s85, 1024
    s_movk_i32 s15, 8192
    buffer_load_dwordx4 v9, s[76:79], s15 offen nt lds
    s_waitcnt vmcnt(9)
    s_add_u32 m0, s84, 4096
    s_mov_b32 s15, 32768
    buffer_load_dwordx4 v7, s[56:59], s15 offen nt lds
    s_waitcnt vmcnt(9)
    s_xor_b32 s11, s74, 229376
    buffer_load_dwordx4 v[224:227], v4, s[44:47], s11 offen offset:0 nt
    s_waitcnt vmcnt(9)
    buffer_load_dwordx4 v[228:231], v4, s[44:47], s11 offen offset:128 nt
    s_waitcnt vmcnt(9)
    buffer_load_dwordx4 v[232:235], v4, s[44:47], s11 offen offset:2048 nt
    buffer_load_dwordx4 v[236:239], v4, s[44:47], s11 offen offset:2176 nt
    s_add_u32 m0, s84, 5120
    s_mov_b32 s15, 34816
    buffer_load_dwordx4 v7, s[56:59], s15 offen nt lds
    s_xor_b32 s12, s74, 0
    buffer_load_dwordx4 v[240:243], v5, s[48:51], s12 offen offset:0 nt
    s_cmp_lg_u32 s3, 0
    s_cbranch_scc1 L_skip_21
    s_mov_b32 s89, 0
L_gaspin_22:
    v_max3_u32 v106, v56, v57, v58
    v_max3_u32 v106, v106, v59, v60
    v_max3_u32 v106, v106, v61, v62
    v_max3_u32 v106, v106, v63, v64
    v_max3_u32 v106, v106, v65, v66
    v_max3_u32 v106, v106, v67, v68
    v_max3_u32 v106, v106, v69, v70
    v_max_u32 v106, v106, v71
    v_cmp_eq_u32 vcc, -1, v106
    s_cbranch_vccz L_gaok_23
    s_lshl_b32 s8, s4, 13
    s_lshl_b32 s9, s5, 7
    s_add_u32 s8, s8, s9
    s_add_u32 s8, s8, 102400
    v_and_b32 v104, 7, v1
    v_lshlrev_b32 v104, 4, v104
    v_bfe_u32 v105, v1, 3, 2
    v_lshl_add_u32 v104, v105, 8, v104
    v_lshrrev_b32 v105, 5, v1
    v_lshl_add_u32 v104, v105, 10, v104
    s_add_u32 s9, s8, 4096
    buffer_load_dwordx4 v[56:59], v104, s[80:83], s8 offen offset:0 sc1
    buffer_load_dwordx4 v[60:63], v104, s[80:83], s8 offen offset:2048 sc1
    buffer_load_dwordx4 v[64:67], v104, s[80:83], s9 offen offset:0 sc1
    buffer_load_dwordx4 v[68:71], v104, s[80:83], s9 offen offset:2048 sc1
    s_add_u32 s89, s89, 1
    s_cmp_lt_u32 s89, 0x4000
    s_waitcnt vmcnt(0)
    s_cbranch_scc1 L_gaspin_22
L_gaok_23:
    v_add_f32 v56, v56, v60
    v_add_f32 v57, v57, v61
    v_add_f32 v58, v58, v62
    v_add_f32 v59, v59, v63
    v_add_f32 v56, v56, v64
    v_add_f32 v57, v57, v65
    v_add_f32 v58, v58, v66
    v_add_f32 v59, v59, v67
    v_add_f32 v56, v56, v68
    v_add_f32 v57, v57, v69
    v_add_f32 v58, v58, v70
    v_add_f32 v59, v59, v71
    v_and_b32 v105, 7, v1
    v_lshrrev_b32 v106, 5, v1
    v_permlane32_swap_b32 v56, v57
    v_permlane32_swap_b32 v58, v59
    v_lshl_add_u32 v105, v106, 3, v105
    v_add_f32 v56, v56, v57
    v_add_f32 v58, v58, v59
    v_cvt_pk_bf16_f32 v56, v56, v58
    v_bfe_u32 v104, v1, 3, 2
    v_lshl_add_u32 v104, v104, 5, v105
    v_lshlrev_b32 v104, 1, v104
    ds_write_b16 v104, v56 offset:0
    ds_write_b16_d16_hi v104, v56 offset:32
L_skip_21:
    v_and_b32 v104, 8, v1
    v_lshlrev_b32 v104, 3, v104
    v_lshl_add_u32 v104, v3, 4, v104
    s_waitcnt lgkmcnt(0)
    s_barrier
    ds_read_b128 v[40:43], v104 offset:0
    ds_read_b128 v[44:47], v104 offset:128
    s_waitcnt lgkmcnt(0)
    v_mfma_f32_16x16x32_bf16 v[56:59], v[112:115], v[40:43], 0
    v_mfma_f32_16x16x32_bf16 v[48:51], v[120:123], v[40:43], 0
    v_mfma_f32_16x16x32_bf16 v[56:59], v[116:119], v[44:47], v[56:59]
    v_mfma_f32_16x16x32_bf16 v[48:51], v[124:127], v[44:47], v[48:51]
    v_mfma_f32_16x16x32_bf16 v[60:63], v[128:131], v[40:43], 0
    v_mfma_f32_16x16x32_bf16 v[52:55], v[136:139], v[40:43], 0
    v_mfma_f32_16x16x32_bf16 v[60:63], v[132:135], v[44:47], v[60:63]
    v_mfma_f32_16x16x32_bf16 v[52:55], v[140:143], v[44:47], v[52:55]
    s_nop 3
    v_permlane32_swap_b32 v56, v48
    v_permlane32_swap_b32 v57, v49
    v_permlane32_swap_b32 v58, v50
    v_permlane32_swap_b32 v59, v51
    v_add_f32_dpp v56, v48, v56 row_ror:8 row_mask:0xf bank_mask:0xf
    v_add_f32_dpp v57, v49, v57 row_ror:8 row_mask:0xf bank_mask:0xf
    v_add_f32_dpp v58, v50, v58 row_ror:8 row_mask:0xf bank_mask:0xf
    v_add_f32_dpp v59, v51, v59 row_ror:8 row_mask:0xf bank_mask:0xf
    v_mfma_f32_16x16x32_bf16 v[64:67], v[144:147], v[40:43], 0
    v_mfma_f32_16x16x32_bf16 v[48:51], v[152:155], v[40:43], 0
    v_mfma_f32_16x16x32_bf16 v[64:67], v[148:151], v[44:47], v[64:67]
    v_mfma_f32_16x16x32_bf16 v[48:51], v[156:159], v[44:47], v[48:51]
    s_nop 3
    v_permlane32_swap_b32 v60, v52
    v_permlane32_swap_b32 v61, v53
    v_permlane32_swap_b32 v62, v54
    v_permlane32_swap_b32 v63, v55
    v_add_f32_dpp v60, v52, v60 row_ror:8 row_mask:0xf bank_mask:0xf
    v_add_f32_dpp v61, v53, v61 row_ror:8 row_mask:0xf bank_mask:0xf
    v_add_f32_dpp v62, v54, v62 row_ror:8 row_mask:0xf bank_mask:0xf
    v_add_f32_dpp v63, v55, v63 row_ror:8 row_mask:0xf bank_mask:0xf
    v_mfma_f32_16x16x32_bf16 v[68:71], v[160:163], v[40:43], 0
    v_mfma_f32_16x16x32_bf16 v[52:55], v[168:171], v[40:43], 0
    v_mfma_f32_16x16x32_bf16 v[68:71], v[164:167], v[44:47], v[68:71]
    v_mfma_f32_16x16x32_bf16 v[52:55], v[172:175], v[44:47], v[52:55]
    s_nop 3
    v_permlane32_swap_b32 v64, v48
    v_permlane32_swap_b32 v65, v49
    v_permlane32_swap_b32 v66, v50
    v_permlane32_swap_b32 v67, v51
    v_add_f32_dpp v64, v48, v64 row_ror:8 row_mask:0xf bank_mask:0xf
    v_add_f32_dpp v65, v49, v65 row_ror:8 row_mask:0xf bank_mask:0xf
    v_add_f32_dpp v66, v50, v66 row_ror:8 row_mask:0xf bank_mask:0xf
    v_add_f32_dpp v67, v51, v67 row_ror:8 row_mask:0xf bank_mask:0xf
    v_mfma_f32_16x16x32_bf16 v[72:75], v[176:179], v[40:43], 0
    v_mfma_f32_16x16x32_bf16 v[48:51], v[184:187], v[40:43], 0
    v_mfma_f32_16x16x32_bf16 v[72:75], v[180:183], v[44:47], v[72:75]
    v_mfma_f32_16x16x32_bf16 v[48:51], v[188:191], v[44:47], v[48:51]
    s_nop 3
    v_permlane32_swap_b32 v68, v52
    v_permlane32_swap_b32 v69, v53
    v_permlane32_swap_b32 v70, v54
    v_permlane32_swap_b32 v71, v55
    v_add_f32_dpp v68, v52, v68 row_ror:8 row_mask:0xf bank_mask:0xf
    v_add_f32_dpp v69, v53, v69 row_ror:8 row_mask:0xf bank_mask:0xf
    v_add_f32_dpp v70, v54, v70 row_ror:8 row_mask:0xf bank_mask:0xf
    v_add_f32_dpp v71, v55, v71 row_ror:8 row_mask:0xf bank_mask:0xf
    v_mfma_f32_16x16x32_bf16 v[76:79], v[192:195], v[40:43], 0
    v_mfma_f32_16x16x32_bf16 v[52:55], v[200:203], v[40:43], 0
    v_mfma_f32_16x16x32_bf16 v[76:79], v[196:199], v[44:47], v[76:79]
    v_mfma_f32_16x16x32_bf16 v[52:55], v[204:207], v[44:47], v[52:55]
    s_nop 3
    v_permlane32_swap_b32 v72, v48
    v_permlane32_swap_b32 v73, v49
    v_permlane32_swap_b32 v74, v50
    v_permlane32_swap_b32 v75, v51
    v_add_f32_dpp v72, v48, v72 row_ror:8 row_mask:0xf bank_mask:0xf
    v_add_f32_dpp v73, v49, v73 row_ror:8 row_mask:0xf bank_mask:0xf
    v_add_f32_dpp v74, v50, v74 row_ror:8 row_mask:0xf bank_mask:0xf
    v_add_f32_dpp v75, v51, v75 row_ror:8 row_mask:0xf bank_mask:0xf
    s_waitcnt vmcnt(11)
    buffer_load_dwordx4 v[244:247], v5, s[48:51], s12 offen offset:256 nt
    s_waitcnt vmcnt(11)
    buffer_load_dwordx4 v[248:251], v5, s[48:51], s12 offen offset:512 nt
    s_waitcnt vmcnt(11)
    buffer_load_dwordx4 v[252:255], v5, s[48:51], s12 offen offset:768 nt
    s_waitcnt vmcnt(11)
    v_mfma_f32_16x16x32_bf16 v[80:83], v[208:211], v[40:43], 0
    v_mfma_f32_16x16x32_bf16 v[48:51], v[216:219], v[40:43], 0
    v_mfma_f32_16x16x32_bf16 v[80:83], v[212:215], v[44:47], v[80:83]
    v_mfma_f32_16x16x32_bf16 v[48:51], v[220:223], v[44:47], v[48:51]
    s_nop 3
    v_permlane32_swap_b32 v76, v52
    v_permlane32_swap_b32 v77, v53
    v_permlane32_swap_b32 v78, v54
    v_permlane32_swap_b32 v79, v55
    v_add_f32_dpp v76, v52, v76 row_ror:8 row_mask:0xf bank_mask:0xf
    v_add_f32_dpp v77, v53, v77 row_ror:8 row_mask:0xf bank_mask:0xf
    v_add_f32_dpp v78, v54, v78 row_ror:8 row_mask:0xf bank_mask:0xf
    v_add_f32_dpp v79, v55, v79 row_ror:8 row_mask:0xf bank_mask:0xf
    s_add_u32 m0, s84, 6144
    s_mov_b32 s15, 36864
    buffer_load_dwordx4 v7, s[56:59], s15 offen nt lds
    s_waitcnt vmcnt(11)
    s_add_u32 m0, s84, 7168
    s_mov_b32 s15, 38912
    buffer_load_dwordx4 v7, s[56:59], s15 offen nt lds
    s_waitcnt vmcnt(11)
    s_xor_b32 s12, s74, 32768
    buffer_load_dwordx4 v[112:115], v5, s[48:51], s12 offen offset:0 nt
    s_waitcnt vmcnt(11)
    buffer_load_dwordx4 v[116:119], v5, s[48:51], s12 offen offset:256 nt
    s_waitcnt vmcnt(11)
    buffer_load_dwordx4 v[120:123], v5, s[48:51], s12 offen offset:512 nt
    s_waitcnt vmcnt(11)
    buffer_load_dwordx4 v[124:127], v5, s[48:51], s12 offen offset:768 nt
    s_waitcnt vmcnt(11)
    v_mfma_f32_16x16x32_bf16 v[84:87], v[224:227], v[40:43], 0
    v_mfma_f32_16x16x32_bf16 v[52:55], v[232:235], v[40:43], 0
    v_mfma_f32_16x16x32_bf16 v[84:87], v[228:231], v[44:47], v[84:87]
    v_mfma_f32_16x16x32_bf16 v[52:55], v[236:239], v[44:47], v[52:55]
    s_nop 3
    v_permlane32_swap_b32 v80, v48
    v_permlane32_swap_b32 v81, v49
    v_permlane32_swap_b32 v82, v50
    v_permlane32_swap_b32 v83, v51
    v_add_f32_dpp v80, v48, v80 row_ror:8 row_mask:0xf bank_mask:0xf
    v_add_f32_dpp v81, v49, v81 row_ror:8 row_mask:0xf bank_mask:0xf
    v_add_f32_dpp v82, v50, v82 row_ror:8 row_mask:0xf bank_mask:0xf
    v_add_f32_dpp v83, v51, v83 row_ror:8 row_mask:0xf bank_mask:0xf
    s_cmp_lg_u32 s3, 3
    s_cbranch_scc1 L_skip_24
    v_and_b32 v10, 31, v1
    v_lshlrev_b32 v10, 3, v10
    global_load_dword v111, v10, s[38:39] sc1
L_skip_24:
    s_add_u32 m0, s84, 8192
    s_mov_b32 s15, 65536
    buffer_load_dwordx4 v7, s[56:59], s15 offen nt lds
    s_xor_b32 s12, s74, 65536
    buffer_load_dwordx4 v[128:131], v5, s[48:51], s12 offen offset:0 nt
    buffer_load_dwordx4 v[132:135], v5, s[48:51], s12 offen offset:256 nt
    buffer_load_dwordx4 v[136:139], v5, s[48:51], s12 offen offset:512 nt
    buffer_load_dwordx4 v[140:143], v5, s[48:51], s12 offen offset:768 nt
    s_add_u32 m0, s84, 9216
    s_mov_b32 s15, 67584
    buffer_load_dwordx4 v7, s[56:59], s15 offen nt lds
    v_max3_f32 v38, v56, v57, v58
    v_max3_f32 v38, v38, v59, v60
    v_max3_f32 v38, v38, v61, v62
    v_max3_f32 v38, v38, v63, v64
    v_max3_f32 v38, v38, v65, v66
    v_max3_f32 v38, v38, v67, v68
    v_max3_f32 v38, v38, v69, v70
    v_max3_f32 v38, v38, v71, v72
    v_max3_f32 v38, v38, v73, v74
    v_max3_f32 v38, v38, v75, v76
    v_max3_f32 v38, v38, v77, v78
    v_max3_f32 v38, v38, v79, v80
    v_max3_f32 v38, v38, v81, v82
    v_permlane32_swap_b32 v84, v52
    v_permlane32_swap_b32 v85, v53
    v_permlane32_swap_b32 v86, v54
    v_permlane32_swap_b32 v87, v55
    v_add_f32_dpp v84, v52, v84 row_ror:8 row_mask:0xf bank_mask:0xf
    v_add_f32_dpp v85, v53, v85 row_ror:8 row_mask:0xf bank_mask:0xf
    v_add_f32_dpp v86, v54, v86 row_ror:8 row_mask:0xf bank_mask:0xf
    v_add_f32_dpp v87, v55, v87 row_ror:8 row_mask:0xf bank_mask:0xf
    v_max3_f32 v38, v38, v83, v84
    v_max3_f32 v38, v38, v85, v86
    v_max_f32 v38, v38, v87
    v_mov_b32 v104, v38
    s_nop 1
    v_permlane16_swap_b32 v38, v104
    s_nop 0
    v_max_f32 v38, v38, v104
    v_mov_b32 v104, v38
    s_nop 1
    v_permlane32_swap_b32 v38, v104
    s_nop 0
    v_max_f32 v38, v38, v104
    s_lshl_b32 s8, s3, 2
    v_mov_b32 v108, s8
    v_mov_b32 v109, 0
    s_mov_b64 exec, 1
    ds_write_b32 v108, v38 offset:384
    s_mov_b64 exec, -1
    s_waitcnt lgkmcnt(0)
    s_barrier
    ds_read_b128 v[24:27], v109 offset:384
    ds_read_b128 v[28:31], v109 offset:400
    s_waitcnt lgkmcnt(0)
    v_max3_f32 v38, v24, v25, v26
    v_max3_f32 v38, v38, v27, v28
    v_max3_f32 v38, v38, v29, v30
    v_max_f32 v38, v38, v31
    v_mul_f32 v38, s88, v38
    v_fma_f32 v56, v56, s88, -v38
    v_fma_f32 v57, v57, s88, -v38
    v_fma_f32 v58, v58, s88, -v38
    v_fma_f32 v59, v59, s88, -v38
    v_fma_f32 v60, v60, s88, -v38
    v_fma_f32 v61, v61, s88, -v38
    v_fma_f32 v62, v62, s88, -v38
    v_fma_f32 v63, v63, s88, -v38
    v_fma_f32 v64, v64, s88, -v38
    v_fma_f32 v65, v65, s88, -v38
    v_fma_f32 v66, v66, s88, -v38
    v_fma_f32 v67, v67, s88, -v38
    v_fma_f32 v68, v68, s88, -v38
    v_fma_f32 v69, v69, s88, -v38
    v_fma_f32 v70, v70, s88, -v38
    v_fma_f32 v71, v71, s88, -v38
    v_fma_f32 v72, v72, s88, -v38
    v_fma_f32 v73, v73, s88, -v38
    v_fma_f32 v74, v74, s88, -v38
    v_fma_f32 v75, v75, s88, -v38
    v_fma_f32 v76, v76, s88, -v38
    v_fma_f32 v77, v77, s88, -v38
    v_fma_f32 v78, v78, s88, -v38
    v_fma_f32 v79, v79, s88, -v38
    v_fma_f32 v80, v80, s88, -v38
    v_fma_f32 v81, v81, s88, -v38
    v_fma_f32 v82, v82, s88, -v38
    v_fma_f32 v83, v83, s88, -v38
    v_fma_f32 v84, v84, s88, -v38
    v_fma_f32 v85, v85, s88, -v38
    v_fma_f32 v86, v86, s88, -v38
    v_fma_f32 v87, v87, s88, -v38
    v_exp_f32 v56, v56
    v_exp_f32 v57, v57
    v_exp_f32 v58, v58
    v_exp_f32 v59, v59
    v_exp_f32 v60, v60
    v_exp_f32 v61, v61
    v_exp_f32 v62, v62
    v_exp_f32 v63, v63
    v_exp_f32 v64, v64
    v_exp_f32 v65, v65
    v_exp_f32 v66, v66
    v_exp_f32 v67, v67
    v_exp_f32 v68, v68
    v_exp_f32 v69, v69
    v_exp_f32 v70, v70
    v_exp_f32 v71, v71
    v_exp_f32 v72, v72
    v_exp_f32 v73, v73
    v_exp_f32 v74, v74
    v_exp_f32 v75, v75
    v_exp_f32 v76, v76
    v_exp_f32 v77, v77
    v_exp_f32 v78, v78
    v_exp_f32 v79, v79
    v_exp_f32 v80, v80
    v_exp_f32 v81, v81
    v_exp_f32 v82, v82
    v_exp_f32 v83, v83
    v_exp_f32 v84, v84
    v_exp_f32 v85, v85
    v_exp_f32 v86, v86
    v_exp_f32 v87, v87
    v_add_f32 v10, v56, v57
    v_add_f32 v104, v58, v59
    v_add_f32 v10, v10, v60
    v_add_f32 v104, v104, v61
    v_add_f32 v10, v10, v62
    v_add_f32 v104, v104, v63
    v_add_f32 v10, v10, v64
    v_add_f32 v104, v104, v65
    v_add_f32 v10, v10, v66
    v_add_f32 v104, v104, v67
    v_add_f32 v10, v10, v68
    v_add_f32 v104, v104, v69
    v_add_f32 v10, v10, v70
    v_add_f32 v104, v104, v71
    v_add_f32 v10, v10, v72
    v_add_f32 v104, v104, v73
    v_add_f32 v10, v10, v74
    v_add_f32 v104, v104, v75
    v_add_f32 v10, v10, v76
    v_add_f32 v104, v104, v77
    v_add_f32 v10, v10, v78
    v_add_f32 v104, v104, v79
    v_add_f32 v10, v10, v80
    v_add_f32 v104, v104, v81
    v_add_f32 v10, v10, v82
    v_add_f32 v104, v104, v83
    v_add_f32 v10, v10, v84
    v_add_f32 v104, v104, v85
    v_add_f32 v10, v10, v86
    v_add_f32 v104, v104, v87
    v_add_f32 v10, v10, v104
    v_mov_b32 v104, v10
    s_nop 1
    v_permlane16_swap_b32 v10, v104
    s_nop 0
    v_add_f32 v10, v10, v104
    v_mov_b32 v104, v10
    s_nop 1
    v_permlane32_swap_b32 v10, v104
    s_nop 0
    v_add_f32 v10, v10, v104
    s_mov_b64 exec, 1
    ds_write_b32 v108, v10 offset:448
    s_mov_b64 exec, -1
    v_cvt_pk_bf16_f32 v56, v56, v56
    v_cvt_pk_bf16_f32 v57, v57, v57
    v_cvt_pk_bf16_f32 v58, v58, v58
    v_cvt_pk_bf16_f32 v59, v59, v59
    v_cvt_pk_bf16_f32 v60, v60, v60
    v_cvt_pk_bf16_f32 v61, v61, v61
    v_cvt_pk_bf16_f32 v62, v62, v62
    v_cvt_pk_bf16_f32 v63, v63, v63
    v_cvt_pk_bf16_f32 v64, v64, v64
    v_cvt_pk_bf16_f32 v65, v65, v65
    v_cvt_pk_bf16_f32 v66, v66, v66
    v_cvt_pk_bf16_f32 v67, v67, v67
    v_cvt_pk_bf16_f32 v68, v68, v68
    v_cvt_pk_bf16_f32 v69, v69, v69
    v_cvt_pk_bf16_f32 v70, v70, v70
    v_cvt_pk_bf16_f32 v71, v71, v71
    v_cvt_pk_bf16_f32 v72, v72, v72
    v_cvt_pk_bf16_f32 v73, v73, v73
    v_cvt_pk_bf16_f32 v74, v74, v74
    v_cvt_pk_bf16_f32 v75, v75, v75
    v_cvt_pk_bf16_f32 v76, v76, v76
    v_cvt_pk_bf16_f32 v77, v77, v77
    v_cvt_pk_bf16_f32 v78, v78, v78
    v_cvt_pk_bf16_f32 v79, v79, v79
    v_cvt_pk_bf16_f32 v80, v80, v80
    v_cvt_pk_bf16_f32 v81, v81, v81
    v_cvt_pk_bf16_f32 v82, v82, v82
    v_cvt_pk_bf16_f32 v83, v83, v83
    v_cvt_pk_bf16_f32 v84, v84, v84
    v_cvt_pk_bf16_f32 v85, v85, v85
    v_cvt_pk_bf16_f32 v86, v86, v86
    v_cvt_pk_bf16_f32 v87, v87, v87
    s_waitcnt lgkmcnt(0)
    s_barrier
    s_cmp_lg_u32 s3, 2
    s_cbranch_scc1 L_skip_25
    ds_read_b128 v[24:27], v109 offset:448
    ds_read_b128 v[28:31], v109 offset:464
    s_lshl_b32 s8, s2, 7
    s_add_u32 s8, s8, 69640
    s_waitcnt lgkmcnt(0)
    v_add_f32 v24, v24, v25
    v_add_f32 v24, v24, v26
    v_add_f32 v24, v24, v27
    v_add_f32 v24, v24, v28
    v_add_f32 v24, v24, v29
    v_add_f32 v24, v24, v30
    v_add_f32 v24, v24, v31
    v_min_u32 v105, -2, v24
    v_mov_b32 v104, v38
    s_mov_b64 exec, 1
    buffer_store_dwordx2 v[104:105], v109, s[80:83], s8 offen sc1
    s_mov_b64 exec, -1
L_skip_25:
    s_waitcnt vmcnt(12)
    v_and_b32 v24, v56, v12
    v_and_b32 v25, v56, v13
    v_and_b32 v26, v56, v14
    v_and_b32 v27, v56, v15
    v_and_b32 v28, v57, v12
    v_and_b32 v29, v57, v13
    v_and_b32 v30, v57, v14
    v_and_b32 v31, v57, v15
    v_mfma_f32_16x16x32_bf16 v[32:35], v[240:243], v[24:27], 0
    v_and_b32 v24, v58, v12
    v_and_b32 v25, v58, v13
    v_and_b32 v26, v58, v14
    v_and_b32 v27, v58, v15
    v_mfma_f32_16x16x32_bf16 v[32:35], v[244:247], v[28:31], v[32:35]
    v_and_b32 v28, v59, v12
    v_and_b32 v29, v59, v13
    v_and_b32 v30, v59, v14
    v_and_b32 v31, v59, v15
    v_mfma_f32_16x16x32_bf16 v[32:35], v[248:251], v[24:27], v[32:35]
    v_and_b32 v24, v60, v12
    v_and_b32 v25, v60, v13
    v_and_b32 v26, v60, v14
    v_and_b32 v27, v60, v15
    v_mfma_f32_16x16x32_bf16 v[32:35], v[252:255], v[28:31], v[32:35]
    s_waitcnt vmcnt(11)
    s_add_u32 m0, s84, 10240
    s_mov_b32 s15, 69632
    buffer_load_dwordx4 v7, s[56:59], s15 offen nt lds
    s_waitcnt vmcnt(11)
    s_xor_b32 s12, s74, 98304
    buffer_load_dwordx4 v[144:147], v5, s[48:51], s12 offen offset:0 nt
    s_waitcnt vmcnt(11)
    buffer_load_dwordx4 v[148:151], v5, s[48:51], s12 offen offset:256 nt
    s_waitcnt vmcnt(11)
    buffer_load_dwordx4 v[152:155], v5, s[48:51], s12 offen offset:512 nt
    s_waitcnt vmcnt(11)
    buffer_load_dwordx4 v[156:159], v5, s[48:51], s12 offen offset:768 nt
    s_waitcnt vmcnt(11)
    v_and_b32 v28, v61, v12
    v_and_b32 v29, v61, v13
    v_and_b32 v30, v61, v14
    v_and_b32 v31, v61, v15
    v_mfma_f32_16x16x32_bf16 v[32:35], v[112:115], v[24:27], v[32:35]
    v_and_b32 v24, v62, v12
    v_and_b32 v25, v62, v13
    v_and_b32 v26, v62, v14
    v_and_b32 v27, v62, v15
    v_mfma_f32_16x16x32_bf16 v[32:35], v[116:119], v[28:31], v[32:35]
    v_and_b32 v28, v63, v12
    v_and_b32 v29, v63, v13
    v_and_b32 v30, v63, v14
    v_and_b32 v31, v63, v15
    v_mfma_f32_16x16x32_bf16 v[32:35], v[120:123], v[24:27], v[32:35]
    v_and_b32 v24, v64, v12
    v_and_b32 v25, v64, v13
    v_and_b32 v26, v64, v14
    v_and_b32 v27, v64, v15
    v_mfma_f32_16x16x32_bf16 v[32:35], v[124:127], v[28:31], v[32:35]
    s_add_u32 m0, s84, 11264
    s_mov_b32 s15, 71680
    buffer_load_dwordx4 v7, s[56:59], s15 offen nt lds
    s_waitcnt vmcnt(11)
    s_cmp_lg_u32 s3, 3
    s_cbranch_scc1 L_skip_26
    v_cmp_gt_u32 vcc, 8, v111
    s_cbranch_vccz L_flok_27
    s_mov_b32 s89, 0
L_flspin_28:
    s_sleep 32
    v_and_b32 v10, 31, v1
    v_lshlrev_b32 v10, 3, v10
    global_load_dword v111, v10, s[38:39] sc1
    s_add_u32 s89, s89, 1
    s_cmp_ge_u32 s89, 0x4000
    s_waitcnt vmcnt(0)
    s_cbranch_scc1 L_flok_27
    v_cmp_gt_u32 vcc, 8, v111
    s_cbranch_vccnz L_flspin_28
L_flok_27:
    s_lshr_b32 s8, s7, 3
    s_lshl_b32 s8, s8, 13
    s_lshl_b32 s9, s5, 7
    s_add_u32 s8, s8, s9
    s_bfe_u32 s9, s7, 0x20001
    s_lshl_b32 s9, s9, 8
    s_add_u32 s8, s8, s9
    s_and_b32 s9, s7, 1
    s_lshl_b32 s9, s9, 3
    s_add_u32 s8, s8, s9
    s_add_u32 s8, s8, 364544
    v_and_b32 v10, 7, v1
    v_lshlrev_b32 v10, 4, v10
    v_lshrrev_b32 v104, 3, v1
    v_lshl_add_u32 v10, v104, 10, v10
    buffer_load_dwordx2 v[96:97], v10, s[80:83], s8 offen sc1
    s_add_u32 s8, s8, 90112
    buffer_load_dwordx2 v[98:99], v10, s[80:83], s8 offen sc1
L_skip_26:
    s_xor_b32 s12, s74, 131072
    buffer_load_dwordx4 v[160:163], v5, s[48:51], s12 offen offset:0 nt
    s_waitcnt vmcnt(11)
    buffer_load_dwordx4 v[164:167], v5, s[48:51], s12 offen offset:256 nt
    s_waitcnt vmcnt(11)
    buffer_load_dwordx4 v[168:171], v5, s[48:51], s12 offen offset:512 nt
    s_waitcnt vmcnt(11)
    buffer_load_dwordx4 v[172:175], v5, s[48:51], s12 offen offset:768 nt
    s_waitcnt vmcnt(11)
    v_and_b32 v28, v65, v12
    v_and_b32 v29, v65, v13
    v_and_b32 v30, v65, v14
    v_and_b32 v31, v65, v15
    v_mfma_f32_16x16x32_bf16 v[32:35], v[128:131], v[24:27], v[32:35]
    v_and_b32 v24, v66, v12
    v_and_b32 v25, v66, v13
    v_and_b32 v26, v66, v14
    v_and_b32 v27, v66, v15
    v_mfma_f32_16x16x32_bf16 v[32:35], v[132:135], v[28:31], v[32:35]
    v_and_b32 v28, v67, v12
    v_and_b32 v29, v67, v13
    v_and_b32 v30, v67, v14
    v_and_b32 v31, v67, v15
    v_mfma_f32_16x16x32_bf16 v[32:35], v[136:139], v[24:27], v[32:35]
    v_and_b32 v24, v68, v12
    v_and_b32 v25, v68, v13
    v_and_b32 v26, v68, v14
    v_and_b32 v27, v68, v15
    v_mfma_f32_16x16x32_bf16 v[32:35], v[140:143], v[28:31], v[32:35]
    s_add_u32 m0, s84, 12288
    s_mov_b32 s15, 98304
    buffer_load_dwordx4 v7, s[56:59], s15 offen nt lds
    s_waitcnt vmcnt(11)
    s_add_u32 m0, s84, 13312
    s_mov_b32 s15, 100352
    buffer_load_dwordx4 v7, s[56:59], s15 offen nt lds
    s_waitcnt vmcnt(11)
    s_xor_b32 s12, s74, 163840
    buffer_load_dwordx4 v[176:179], v5, s[48:51], s12 offen offset:0 nt
    s_waitcnt vmcnt(11)
    buffer_load_dwordx4 v[180:183], v5, s[48:51], s12 offen offset:256 nt
    s_waitcnt vmcnt(11)
    buffer_load_dwordx4 v[184:187], v5, s[48:51], s12 offen offset:512 nt
    s_waitcnt vmcnt(11)
    buffer_load_dwordx4 v[188:191], v5, s[48:51], s12 offen offset:768 nt
    s_waitcnt vmcnt(11)
    v_and_b32 v28, v69, v12
    v_and_b32 v29, v69, v13
    v_and_b32 v30, v69, v14
    v_and_b32 v31, v69, v15
    v_mfma_f32_16x16x32_bf16 v[32:35], v[144:147], v[24:27], v[32:35]
    v_and_b32 v24, v70, v12
    v_and_b32 v25, v70, v13
    v_and_b32 v26, v70, v14
    v_and_b32 v27, v70, v15
    v_mfma_f32_16x16x32_bf16 v[32:35], v[148:151], v[28:31], v[32:35]
    v_and_b32 v28, v71, v12
    v_and_b32 v29, v71, v13
    v_and_b32 v30, v71, v14
    v_and_b32 v31, v71, v15
    v_mfma_f32_16x16x32_bf16 v[32:35], v[152:155], v[24:27], v[32:35]
    v_and_b32 v24, v72, v12
    v_and_b32 v25, v72, v13
    v_and_b32 v26, v72, v14
    v_and_b32 v27, v72, v15
    v_mfma_f32_16x16x32_bf16 v[32:35], v[156:159], v[28:31], v[32:35]
    s_cmp_lg_u32 s3, 3
    s_cbranch_scc1 L_skip_29
    s_lshl_b32 s8, s5, 7
    s_add_u32 s8, s8, s73
    s_lshl_b32 s8, s8, 7
    s_add_u32 s8, s8, 69640
    v_mov_b32 v10, 0
    buffer_load_dwordx2 v[16:17], v10, s[80:83], s8 offen sc1
    s_add_u32 s8, s8, 4096
    buffer_load_dwordx2 v[18:19], v10, s[80:83], s8 offen sc1
    s_add_u32 s8, s8, 4096
    buffer_load_dwordx2 v[20:21], v10, s[80:83], s8 offen sc1
    s_add_u32 s8, s8, 4096
    buffer_load_dwordx2 v[22:23], v10, s[80:83], s8 offen sc1
L_skip_29:
    s_add_u32 m0, s84, 14336
    s_mov_b32 s15, 102400
    buffer_load_dwordx4 v7, s[56:59], s15 offen nt lds
    s_waitcnt vmcnt(11)
    s_add_u32 m0, s84, 15360
    s_mov_b32 s15, 104448
    buffer_load_dwordx4 v7, s[56:59], s15 offen nt lds
    s_waitcnt vmcnt(11)
    s_cmp_lg_u32 s3, 3
    s_cbranch_scc1 L_skip_30
    s_mov_b32 s89, 0
L_fgspin_32:
    v_max3_u32 v104, v96, v97, v98
    v_max_u32 v104, v104, v99
    v_cmp_eq_u32 vcc, -1, v104
    s_cbranch_vccz L_fgok_31
    s_lshr_b32 s8, s7, 3
    s_lshl_b32 s8, s8, 13
    s_lshl_b32 s9, s5, 7
    s_add_u32 s8, s8, s9
    s_bfe_u32 s9, s7, 0x20001
    s_lshl_b32 s9, s9, 8
    s_add_u32 s8, s8, s9
    s_and_b32 s9, s7, 1
    s_lshl_b32 s9, s9, 3
    s_add_u32 s8, s8, s9
    s_add_u32 s8, s8, 364544
    v_and_b32 v10, 7, v1
    v_lshlrev_b32 v10, 4, v10
    v_lshrrev_b32 v104, 3, v1
    v_lshl_add_u32 v10, v104, 10, v10
    buffer_load_dwordx2 v[96:97], v10, s[80:83], s8 offen sc1
    s_add_u32 s8, s8, 90112
    buffer_load_dwordx2 v[98:99], v10, s[80:83], s8 offen sc1
    s_add_u32 s89, s89, 1
    s_cmp_lt_u32 s89, 0x4000
    s_waitcnt vmcnt(0)
    s_cbranch_scc1 L_fgspin_32
L_fgok_31:
    v_permlane32_swap_b32 v96, v97
    v_permlane32_swap_b32 v98, v99
    s_nop 0
    v_add_f32 v96, v96, v97
    v_add_f32 v98, v98, v99
    v_mov_b32 v97, v96
    s_nop 1
    v_permlane16_swap_b32 v96, v97
    s_nop 0
    v_add_f32 v96, v96, v97
    v_mov_b32 v99, v98
    s_nop 1
    v_permlane16_swap_b32 v98, v99
    s_nop 0
    v_add_f32 v98, v98, v99
    s_nop 1
    v_add_f32_dpp v96, v96, v96 row_ror:8 row_mask:0xf bank_mask:0xf
    s_nop 1
    v_add_f32_dpp v98, v98, v98 row_ror:8 row_mask:0xf bank_mask:0xf
    v_cvt_pk_bf16_f32 v96, v96, v98
    v_and_b32 v98, 0xffff0000, v96
    v_lshlrev_b32 v96, 16, v96
    v_mul_f32 v97, v96, v96
    v_mov_b32 v99, 0xc0135761
    v_mul_f32 v97, 0x3d372713, v97
    v_add_f32 v97, 1.0, v97
    v_mul_f32 v97, v97, v96
    v_mul_f32 v97, v97, v99
    v_exp_f32 v97, v97
    s_nop 0
    v_add_f32 v97, 1.0, v97
    v_rcp_f32 v97, v97
    s_nop 0
    v_mul_f32 v96, v96, v97
    v_cvt_pk_bf16_f32 v96, v96, v96
    v_and_b32 v96, 0xffff0000, v96
    v_mul_f32 v96, v96, v98
    v_cvt_pk_bf16_f32 v96, v96, v96
    v_and_b32 v105, 7, v1
    v_lshrrev_b32 v106, 5, v1
    v_lshl_add_u32 v105, v106, 3, v105
    v_lshlrev_b32 v105, 1, v105
    ds_write_b16 v105, v96 offset:256
    v_lshlrev_b32 v105, 3, v3
    v_mov_b32 v107, 0
    s_waitcnt lgkmcnt(0)
    ds_read_b64 v[96:97], v105 offset:256
    ds_read_b32 v98, v107 offset:324
    v_lshrrev_b32 v104, 2, v2
    v_and_b32 v105, 3, v2
    v_lshlrev_b32 v105, 3, v105
    v_lshl_add_u32 v105, v104, 7, v105
    v_lshl_add_u32 v105, v3, 9, v105
    v_lshlrev_b32 v106, 2, v1
    v_cmp_eq_u32 s[52:53], 1, v3
    v_cmp_eq_u32 s[54:55], 2, v3
    v_cmp_eq_u32 s[68:69], 3, v3
    ds_read_b64_tr_b16 v[88:89], v105 offset:5120
    ds_read_b64_tr_b16 v[90:91], v105 offset:5152
    ds_read_b64_tr_b16 v[92:93], v105 offset:5184
    ds_read_b64_tr_b16 v[94:95], v105 offset:5216
    ds_read_b64_tr_b16 v[144:145], v105 offset:7168
    ds_read_b64_tr_b16 v[146:147], v105 offset:7200
    ds_read_b64_tr_b16 v[148:149], v105 offset:7232
    ds_read_b64_tr_b16 v[150:151], v105 offset:7264
    s_waitcnt lgkmcnt(4)
    v_mfma_f32_16x16x16_bf16 v[128:131], v[96:97], v[88:89], 0
    v_mfma_f32_16x16x16_bf16 v[132:135], v[96:97], v[90:91], 0
    v_mfma_f32_16x16x16_bf16 v[136:139], v[96:97], v[92:93], 0
    v_mfma_f32_16x16x16_bf16 v[140:143], v[96:97], v[94:95], 0
    s_nop 5
    v_cndmask_b32 v108, v128, v132, s[52:53]
    s_nop 0
    v_cndmask_b32 v108, v108, v136, s[54:55]
    s_nop 0
    v_cndmask_b32 v108, v108, v140, s[68:69]
    v_mul_f32 v108, v108, v98
    ds_write_b32 v106, v108 offset:3072
    ds_read_b64_tr_b16 v[88:89], v105 offset:9216
    ds_read_b64_tr_b16 v[90:91], v105 offset:9248
    ds_read_b64_tr_b16 v[92:93], v105 offset:9280
    ds_read_b64_tr_b16 v[94:95], v105 offset:9312
    s_waitcnt lgkmcnt(5)
    v_mfma_f32_16x16x16_bf16 v[128:131], v[96:97], v[144:145], 0
    v_mfma_f32_16x16x16_bf16 v[132:135], v[96:97], v[146:147], 0
    v_mfma_f32_16x16x16_bf16 v[136:139], v[96:97], v[148:149], 0
    v_mfma_f32_16x16x16_bf16 v[140:143], v[96:97], v[150:151], 0
    s_nop 5
    v_cndmask_b32 v108, v128, v132, s[52:53]
    s_nop 0
    v_cndmask_b32 v108, v108, v136, s[54:55]
    s_nop 0
    v_cndmask_b32 v108, v108, v140, s[68:69]
    v_mul_f32 v108, v108, v98
    ds_write_b32 v106, v108 offset:3328
    ds_read_b64_tr_b16 v[144:145], v105 offset:11264
    ds_read_b64_tr_b16 v[146:147], v105 offset:11296
    ds_read_b64_tr_b16 v[148:149], v105 offset:11328
    ds_read_b64_tr_b16 v[150:151], v105 offset:11360
    s_waitcnt lgkmcnt(5)
    v_mfma_f32_16x16x16_bf16 v[128:131], v[96:97], v[88:89], 0
    v_mfma_f32_16x16x16_bf16 v[132:135], v[96:97], v[90:91], 0
    v_mfma_f32_16x16x16_bf16 v[136:139], v[96:97], v[92:93], 0
    v_mfma_f32_16x16x16_bf16 v[140:143], v[96:97], v[94:95], 0
    s_nop 5
    v_cndmask_b32 v108, v128, v132, s[52:53]
    s_nop 0
    v_cndmask_b32 v108, v108, v136, s[54:55]
    s_nop 0
    v_cndmask_b32 v108, v108, v140, s[68:69]
    v_mul_f32 v108, v108, v98
    ds_write_b32 v106, v108 offset:3584
    ds_read_b64_tr_b16 v[88:89], v105 offset:13312
    ds_read_b64_tr_b16 v[90:91], v105 offset:13344
    ds_read_b64_tr_b16 v[92:93], v105 offset:13376
    ds_read_b64_tr_b16 v[94:95], v105 offset:13408
    s_waitcnt lgkmcnt(5)
    v_mfma_f32_16x16x16_bf16 v[128:131], v[96:97], v[144:145], 0
    v_mfma_f32_16x16x16_bf16 v[132:135], v[96:97], v[146:147], 0
    v_mfma_f32_16x16x16_bf16 v[136:139], v[96:97], v[148:149], 0
    v_mfma_f32_16x16x16_bf16 v[140:143], v[96:97], v[150:151], 0
    s_nop 5
    v_cndmask_b32 v108, v128, v132, s[52:53]
    s_nop 0
    v_cndmask_b32 v108, v108, v136, s[54:55]
    s_nop 0
    v_cndmask_b32 v108, v108, v140, s[68:69]
    v_mul_f32 v108, v108, v98
    ds_write_b32 v106, v108 offset:3840
    ds_read_b64_tr_b16 v[144:145], v105 offset:15360
    ds_read_b64_tr_b16 v[146:147], v105 offset:15392
    ds_read_b64_tr_b16 v[148:149], v105 offset:15424
    ds_read_b64_tr_b16 v[150:151], v105 offset:15456
    s_waitcnt lgkmcnt(5)
    v_mfma_f32_16x16x16_bf16 v[128:131], v[96:97], v[88:89], 0
    v_mfma_f32_16x16x16_bf16 v[132:135], v[96:97], v[90:91], 0
    v_mfma_f32_16x16x16_bf16 v[136:139], v[96:97], v[92:93], 0
    v_mfma_f32_16x16x16_bf16 v[140:143], v[96:97], v[94:95], 0
    s_nop 5
    v_cndmask_b32 v108, v128, v132, s[52:53]
    s_nop 0
    v_cndmask_b32 v108, v108, v136, s[54:55]
    s_nop 0
    v_cndmask_b32 v108, v108, v140, s[68:69]
    v_mul_f32 v108, v108, v98
    ds_write_b32 v106, v108 offset:4096
    ds_read_b64_tr_b16 v[88:89], v105 offset:17408
    ds_read_b64_tr_b16 v[90:91], v105 offset:17440
    ds_read_b64_tr_b16 v[92:93], v105 offset:17472
    ds_read_b64_tr_b16 v[94:95], v105 offset:17504
    s_waitcnt lgkmcnt(5)
    v_mfma_f32_16x16x16_bf16 v[128:131], v[96:97], v[144:145], 0
    v_mfma_f32_16x16x16_bf16 v[132:135], v[96:97], v[146:147], 0
    v_mfma_f32_16x16x16_bf16 v[136:139], v[96:97], v[148:149], 0
    v_mfma_f32_16x16x16_bf16 v[140:143], v[96:97], v[150:151], 0
    s_nop 5
    v_cndmask_b32 v108, v128, v132, s[52:53]
    s_nop 0
    v_cndmask_b32 v108, v108, v136, s[54:55]
    s_nop 0
    v_cndmask_b32 v108, v108, v140, s[68:69]
    v_mul_f32 v108, v108, v98
    ds_write_b32 v106, v108 offset:4352
    ds_read_b64_tr_b16 v[144:145], v105 offset:19456
    ds_read_b64_tr_b16 v[146:147], v105 offset:19488
    ds_read_b64_tr_b16 v[148:149], v105 offset:19520
    ds_read_b64_tr_b16 v[150:151], v105 offset:19552
    s_waitcnt lgkmcnt(5)
    v_mfma_f32_16x16x16_bf16 v[128:131], v[96:97], v[88:89], 0
    v_mfma_f32_16x16x16_bf16 v[132:135], v[96:97], v[90:91], 0
    v_mfma_f32_16x16x16_bf16 v[136:139], v[96:97], v[92:93], 0
    v_mfma_f32_16x16x16_bf16 v[140:143], v[96:97], v[94:95], 0
    s_nop 5
    v_cndmask_b32 v108, v128, v132, s[52:53]
    s_nop 0
    v_cndmask_b32 v108, v108, v136, s[54:55]
    s_nop 0
    v_cndmask_b32 v108, v108, v140, s[68:69]
    v_mul_f32 v108, v108, v98
    ds_write_b32 v106, v108 offset:4608
    s_waitcnt lgkmcnt(0)
    v_mfma_f32_16x16x16_bf16 v[128:131], v[96:97], v[144:145], 0
    v_mfma_f32_16x16x16_bf16 v[132:135], v[96:97], v[146:147], 0
    v_mfma_f32_16x16x16_bf16 v[136:139], v[96:97], v[148:149], 0
    v_mfma_f32_16x16x16_bf16 v[140:143], v[96:97], v[150:151], 0
    s_nop 5
    v_cndmask_b32 v108, v128, v132, s[52:53]
    s_nop 0
    v_cndmask_b32 v108, v108, v136, s[54:55]
    s_nop 0
    v_cndmask_b32 v108, v108, v140, s[68:69]
    v_mul_f32 v108, v108, v98
    ds_write_b32 v106, v108 offset:4864
L_skip_30:
    s_xor_b32 s12, s74, 196608
    buffer_load_dwordx4 v[192:195], v5, s[48:51], s12 offen offset:0 nt
    s_waitcnt vmcnt(11)
    buffer_load_dwordx4 v[196:199], v5, s[48:51], s12 offen offset:256 nt
    s_waitcnt vmcnt(11)
    buffer_load_dwordx4 v[200:203], v5, s[48:51], s12 offen offset:512 nt
    s_waitcnt vmcnt(11)
    v_and_b32 v28, v73, v12
    v_and_b32 v29, v73, v13
    v_and_b32 v30, v73, v14
    v_and_b32 v31, v73, v15
    v_mfma_f32_16x16x32_bf16 v[32:35], v[160:163], v[24:27], v[32:35]
    v_and_b32 v24, v74, v12
    v_and_b32 v25, v74, v13
    v_and_b32 v26, v74, v14
    v_and_b32 v27, v74, v15
    v_mfma_f32_16x16x32_bf16 v[32:35], v[164:167], v[28:31], v[32:35]
    v_and_b32 v28, v75, v12
    v_and_b32 v29, v75, v13
    v_and_b32 v30, v75, v14
    v_and_b32 v31, v75, v15
    v_mfma_f32_16x16x32_bf16 v[32:35], v[168:171], v[24:27], v[32:35]
    v_and_b32 v24, v76, v12
    v_and_b32 v25, v76, v13
    v_and_b32 v26, v76, v14
    v_and_b32 v27, v76, v15
    v_mfma_f32_16x16x32_bf16 v[32:35], v[172:175], v[28:31], v[32:35]
    buffer_load_dwordx4 v[204:207], v5, s[48:51], s12 offen offset:768 nt
    s_waitcnt vmcnt(11)
    s_xor_b32 s12, s74, 229376
    buffer_load_dwordx4 v[208:211], v5, s[48:51], s12 offen offset:0 nt
    s_waitcnt vmcnt(11)
    buffer_load_dwordx4 v[212:215], v5, s[48:51], s12 offen offset:256 nt
    s_waitcnt vmcnt(11)
    buffer_load_dwordx4 v[216:219], v5, s[48:51], s12 offen offset:512 nt
    s_waitcnt vmcnt(11)
    buffer_load_dwordx4 v[220:223], v5, s[48:51], s12 offen offset:768 nt
    s_waitcnt vmcnt(10)
    v_and_b32 v28, v77, v12
    v_and_b32 v29, v77, v13
    v_and_b32 v30, v77, v14
    v_and_b32 v31, v77, v15
    v_mfma_f32_16x16x32_bf16 v[32:35], v[176:179], v[24:27], v[32:35]
    v_and_b32 v24, v78, v12
    v_and_b32 v25, v78, v13
    v_and_b32 v26, v78, v14
    v_and_b32 v27, v78, v15
    v_mfma_f32_16x16x32_bf16 v[32:35], v[180:183], v[28:31], v[32:35]
    v_and_b32 v28, v79, v12
    v_and_b32 v29, v79, v13
    v_and_b32 v30, v79, v14
    v_and_b32 v31, v79, v15
    v_mfma_f32_16x16x32_bf16 v[32:35], v[184:187], v[24:27], v[32:35]
    v_and_b32 v24, v80, v12
    v_and_b32 v25, v80, v13
    v_and_b32 v26, v80, v14
    v_and_b32 v27, v80, v15
    v_mfma_f32_16x16x32_bf16 v[32:35], v[188:191], v[28:31], v[32:35]
    s_waitcnt vmcnt(8)
    v_lshrrev_b32 v104, 2, v2
    v_and_b32 v105, 3, v2
    v_lshlrev_b32 v105, 3, v105
    v_lshl_add_u32 v105, v104, 7, v105
    v_lshl_add_u32 v106, v3, 10, v105
    v_add_u32 v6, s84, v106
    ds_read_b64_tr_b16 v[40:41], v6 offset:0
    ds_read_b64_tr_b16 v[42:43], v6 offset:512
    ds_read_b64_tr_b16 v[44:45], v6 offset:4096
    ds_read_b64_tr_b16 v[46:47], v6 offset:4608
    ds_read_b64_tr_b16 v[48:49], v6 offset:8192
    ds_read_b64_tr_b16 v[50:51], v6 offset:8704
    ds_read_b64_tr_b16 v[52:53], v6 offset:12288
    ds_read_b64_tr_b16 v[54:55], v6 offset:12800
    s_waitcnt lgkmcnt(4)
    ds_read_b64_tr_b16 v[224:225], v6 offset:32
    ds_read_b64_tr_b16 v[226:227], v6 offset:544
    ds_read_b64_tr_b16 v[228:229], v6 offset:4128
    ds_read_b64_tr_b16 v[230:231], v6 offset:4640
    ds_read_b64_tr_b16 v[232:233], v6 offset:8224
    ds_read_b64_tr_b16 v[234:235], v6 offset:8736
    ds_read_b64_tr_b16 v[236:237], v6 offset:12320
    ds_read_b64_tr_b16 v[238:239], v6 offset:12832
    s_waitcnt lgkmcnt(4)
    ds_read_b64_tr_b16 v[240:241], v6 offset:64
    ds_read_b64_tr_b16 v[242:243], v6 offset:576
    ds_read_b64_tr_b16 v[244:245], v6 offset:4160
    ds_read_b64_tr_b16 v[246:247], v6 offset:4672
    ds_read_b64_tr_b16 v[248:249], v6 offset:8256
    ds_read_b64_tr_b16 v[250:251], v6 offset:8768
    ds_read_b64_tr_b16 v[252:253], v6 offset:12352
    ds_read_b64_tr_b16 v[254:255], v6 offset:12864
    s_waitcnt lgkmcnt(4)
    ds_read_b64_tr_b16 v[112:113], v6 offset:96
    ds_read_b64_tr_b16 v[114:115], v6 offset:608
    ds_read_b64_tr_b16 v[116:117], v6 offset:4192
    ds_read_b64_tr_b16 v[118:119], v6 offset:4704
    ds_read_b64_tr_b16 v[120:121], v6 offset:8288
    ds_read_b64_tr_b16 v[122:123], v6 offset:8800
    ds_read_b64_tr_b16 v[124:125], v6 offset:12384
    ds_read_b64_tr_b16 v[126:127], v6 offset:12896
    v_and_b32 v104, 7, v2
    s_mul_i32 s9, s3, 144
    s_add_u32 s9, s9, 512
    v_lshl_add_u32 v4, v3, 5, s9
    v_lshl_add_u32 v4, v104, 2, v4
    v_mul_u32_u24 v7, 144, v2
    v_lshl_add_u32 v7, v3, 4, v7
    v_mov_b32 v105, 0x44444444
    v_mov_b32 v106, 0xeeeeeeee
    v_cmp_lt_u32 vcc, 7, v2
    v_mov_b32 v88, 0
    v_mov_b32 v89, 0
    v_mov_b32 v90, 0
    v_mov_b32 v91, 0
    v_mov_b32 v92, 0
    v_mov_b32 v93, 0
    v_mov_b32 v94, 0
    v_mov_b32 v95, 0
    v_mov_b32 v96, 0
    v_mov_b32 v97, 0
    v_mov_b32 v98, 0
    v_mov_b32 v99, 0
    v_mov_b32 v100, 0
    v_mov_b32 v101, 0
    v_mov_b32 v102, 0
    v_mov_b32 v103, 0
    v_cndmask_b32 v37, v105, v106, vcc
    v_mul_u32_u24 v105, 512, v3
    v_lshl_add_u32 v8, v2, 2, v105
    v_add_u32 v106, 8, v2
    v_and_b32 v106, 15, v106
    v_lshl_add_u32 v9, v106, 2, v105
    s_mul_i32 s14, s3, 2048
    s_mul_i32 s9, s5, 16384
    s_add_u32 s14, s14, s9
    s_lshl_b32 s9, s5, 10
    s_lshl_b32 s8, s3, 7
    s_add_u32 s9, s9, s8
    v_lshl_add_u32 v11, v1, 1, s9
    v_cmp_eq_u32 s[52:53], 8, v2
    v_cmp_eq_u32 s[54:55], 0, v2
    v_cmp_gt_u32 s[68:69], 8, v2
    s_mov_b32 s42, 0x42fe0000
    s_lshl_b32 s9, s3, 8
    v_lshl_add_u32 v36, v1, 2, s9
    s_waitcnt lgkmcnt(0)
    v_mov_b32 v6, 0
    s_waitcnt vmcnt(4)
    v_and_b32 v28, v81, v12
    v_and_b32 v29, v81, v13
    v_and_b32 v30, v81, v14
    v_and_b32 v31, v81, v15
    v_mfma_f32_16x16x32_bf16 v[32:35], v[192:195], v[24:27], v[32:35]
    v_and_b32 v24, v82, v12
    v_and_b32 v25, v82, v13
    v_and_b32 v26, v82, v14
    v_and_b32 v27, v82, v15
    v_mfma_f32_16x16x32_bf16 v[32:35], v[196:199], v[28:31], v[32:35]
    v_and_b32 v28, v83, v12
    v_and_b32 v29, v83, v13
    v_and_b32 v30, v83, v14
    v_and_b32 v31, v83, v15
    v_mfma_f32_16x16x32_bf16 v[32:35], v[200:203], v[24:27], v[32:35]
    v_and_b32 v24, v84, v12
    v_and_b32 v25, v84, v13
    v_and_b32 v26, v84, v14
    v_and_b32 v27, v84, v15
    v_mfma_f32_16x16x32_bf16 v[32:35], v[204:207], v[28:31], v[32:35]
    v_and_b32 v180, v85, v12
    v_and_b32 v181, v85, v13
    v_and_b32 v182, v85, v14
    v_and_b32 v183, v85, v15
    v_and_b32 v184, v86, v12
    v_and_b32 v185, v86, v13
    v_and_b32 v186, v86, v14
    v_and_b32 v187, v86, v15
    v_and_b32 v188, v87, v12
    v_and_b32 v189, v87, v13
    v_and_b32 v190, v87, v14
    v_and_b32 v191, v87, v15
    s_cmp_lg_u32 s3, 3
    s_cbranch_scc1 L_skip_33
    v_mov_b32 v107, 0
    ds_read_b32 v106, v107 offset:320
    s_mov_b32 s89, 0
L_stspin_35:
    v_max3_u32 v104, v17, v19, v21
    v_max_u32 v104, v104, v23
    v_cmp_eq_u32 vcc, -1, v104
    s_cbranch_vccz L_stok_34
    s_lshl_b32 s8, s5, 7
    s_add_u32 s8, s8, s73
    s_lshl_b32 s8, s8, 7
    s_add_u32 s8, s8, 69640
    v_mov_b32 v10, 0
    buffer_load_dwordx2 v[16:17], v10, s[80:83], s8 offen sc1
    s_add_u32 s8, s8, 4096
    buffer_load_dwordx2 v[18:19], v10, s[80:83], s8 offen sc1
    s_add_u32 s8, s8, 4096
    buffer_load_dwordx2 v[20:21], v10, s[80:83], s8 offen sc1
    s_add_u32 s8, s8, 4096
    buffer_load_dwordx2 v[22:23], v10, s[80:83], s8 offen sc1
    s_add_u32 s89, s89, 1
    s_cmp_lt_u32 s89, 0x4000
    s_waitcnt vmcnt(0)
    s_cbranch_scc1 L_stspin_35
L_stok_34:
    v_max3_f32 v104, v16, v18, v20
    v_max_f32 v104, v104, v22
    v_sub_f32 v16, v16, v104
    v_sub_f32 v18, v18, v104
    v_sub_f32 v20, v20, v104
    v_sub_f32 v22, v22, v104
    v_sub_f32 v105, v38, v104
    v_exp_f32 v16, v16
    v_exp_f32 v18, v18
    v_exp_f32 v20, v20
    v_exp_f32 v22, v22
    v_exp_f32 v105, v105
    v_mul_f32 v104, v16, v17
    v_fmac_f32 v104, v18, v19
    v_fmac_f32 v104, v20, v21
    v_fmac_f32 v104, v22, v23
    v_rcp_f32 v104, v104
    s_waitcnt lgkmcnt(0)
    v_mul_f32 v105, v106, v105
    v_mul_f32 v104, v104, v105
    ds_write_b32 v107, v104 offset:336
L_skip_33:
    s_waitcnt vmcnt(3)
    s_nop 0
    v_mfma_f32_16x16x32_bf16 v[32:35], v[208:211], v[24:27], v[32:35]
    s_waitcnt vmcnt(2)
    v_mfma_f32_16x16x32_bf16 v[32:35], v[212:215], v[180:183], v[32:35]
    s_waitcnt vmcnt(1)
    v_mfma_f32_16x16x32_bf16 v[32:35], v[216:219], v[184:187], v[32:35]
    s_waitcnt vmcnt(0)
    v_mfma_f32_16x16x32_bf16 v[32:35], v[220:223], v[188:191], v[32:35]
    s_mov_b32 exec_lo, 0xff00ff
    s_mov_b32 exec_hi, 0xff00ff
    s_nop 5
    v_cvt_pk_bf16_f32 v104, v32, v33
    v_cvt_pk_bf16_f32 v105, v34, v35
    ds_write_b32 v4, v104
    ds_write_b32 v4, v105 offset:1152
    s_mov_b64 exec, -1
    s_waitcnt lgkmcnt(0)
    s_barrier
    ds_read_b128 v[56:59], v7 offset:512
    ds_read_b128 v[60:63], v7 offset:576
    ds_read_b32 v108, v6 offset:336
    ds_read_b32 v39, v36 offset:3072
    s_waitcnt lgkmcnt(3)
    v_smfmac_f32_16x16x64_bf16 v[88:91], v[56:59], v[40:47], v37
    v_smfmac_f32_16x16x64_bf16 v[92:95], v[56:59], v[224:231], v37
    v_smfmac_f32_16x16x64_bf16 v[96:99], v[56:59], v[240:247], v37
    v_smfmac_f32_16x16x64_bf16 v[100:103], v[56:59], v[112:119], v37
    s_waitcnt lgkmcnt(2)
    v_smfmac_f32_16x16x64_bf16 v[88:91], v[60:63], v[48:55], v37
    v_smfmac_f32_16x16x64_bf16 v[92:95], v[60:63], v[232:239], v37
    v_smfmac_f32_16x16x64_bf16 v[96:99], v[60:63], v[248:255], v37
    v_smfmac_f32_16x16x64_bf16 v[100:103], v[60:63], v[120:127], v37
    s_waitcnt lgkmcnt(0)
    s_nop 3
    v_add_f32 v88, v88, v89
    v_add_f32 v90, v90, v91
    v_add_f32 v88, v88, v90
    v_add_f32 v92, v92, v93
    v_add_f32 v94, v94, v95
    v_add_f32 v92, v92, v94
    v_add_f32 v96, v96, v97
    v_add_f32 v98, v98, v99
    v_add_f32 v96, v96, v98
    v_add_f32 v100, v100, v101
    v_add_f32 v102, v102, v103
    v_add_f32 v100, v100, v102
    s_nop 0
    v_permlane16_swap_b32 v88, v92
    v_permlane16_swap_b32 v96, v100
    v_add_f32 v88, v88, v92
    v_add_f32 v96, v96, v100
    s_nop 1
    v_permlane32_swap_b32 v88, v96
    v_add_f32 v104, v88, v96
    v_fma_f32 v104, v104, v108, v39
    v_cndmask_b32 v105, v104, 1.0, s[52:53]
    v_cndmask_b32 v106, v104, 1.0, s[54:55]
    s_mov_b32 exec_lo, 0x1ff01ff
    s_mov_b32 exec_hi, 0x1ff01ff
    buffer_atomic_add_f32 v105, v8, s[80:83], s14 offen sc0
    s_mov_b32 exec_lo, 0xff01ff01
    s_mov_b32 exec_hi, 0xff01ff01
    buffer_atomic_add_f32 v106, v9, s[80:83], s14 offen offset:256 sc0
    s_mov_b64 exec, -1
    s_waitcnt vmcnt(0)
    v_mov_b32_dpp v107, v105 row_newbcast:8 row_mask:0xf bank_mask:0xf
    v_mov_b32_dpp v108, v106 row_newbcast:0 row_mask:0xf bank_mask:0xf
    v_cndmask_b32 v105, v106, v105, s[68:69]
    v_cndmask_b32 v107, v108, v107, s[68:69]
    v_add_f32 v104, v104, v105
    v_cmp_eq_f32 vcc, s42, v107
    v_cvt_pk_bf16_f32 v104, v104, v104
    s_and_b64 exec, exec, vcc
    s_cbranch_execz L_fin_36
    global_store_short v11, v104, s[36:37]
L_fin_36:
    s_mov_b64 exec, -1
L_end:
    s_endpgm
.section .rodata,"a"
.p2align 6
.amdhsa_kernel gated_mix__mha_block_cached__geglu_ffn__decode_kernel
  .amdhsa_next_free_vgpr 256
  .amdhsa_next_free_sgpr 102
  .amdhsa_accum_offset 256
  .amdhsa_group_segment_fixed_size 0
  .amdhsa_kernarg_size 104
  .amdhsa_user_sgpr_count 2
  .amdhsa_user_sgpr_kernarg_segment_ptr 1
  .amdhsa_system_sgpr_workgroup_id_x 1
.end_amdhsa_kernel
```
